```python
import torch

def _softmax(x, axis=-1):
    return torch.softmax(x, dim=axis)
def _gelu(x):
    return torch.nn.functional.gelu(x, approximate="tanh")
def _silu(x):
    return torch.nn.functional.silu(x)
def _sigmoid(x):
    return torch.sigmoid(x)
def _layernorm(x, axis=-1, eps=1e-5):
    m = x.mean(dim=axis, keepdim=True)
    v = x.var(dim=axis, keepdim=True, unbiased=False)
    return (x - m) / torch.sqrt(v + eps)
def _scatter_add(tgt, idx, src, axis=0):
    return tgt.clone().index_add_(axis, idx, src)
def _segment_sum(src, seg, n):
    out = torch.zeros((n,) + src.shape[1:], dtype=src.dtype)
    return out.index_add_(0, seg, src)
def _pad(x, pw):
    flat = tuple(v for pair in reversed(pw) for v in pair)
    return torch.nn.functional.pad(x, flat)

kernel_name = 'standalone__structured_sparse_n_m__ragged'

def setup_inputs():

    _w = (lambda a: (lambda t: t.to(torch.bfloat16) if t.is_floating_point() else t)(torch.as_tensor(a)))
    B, S, D = 4, 4096, 1024
    assert D % 4 == 0, "d_model must be divisible by M=4 for 2:4 sparsity"
    return {
        "x": _w((lambda *s: torch.randn(*s, dtype=torch.bfloat16) * 0.05)(B, S, D)),
        "w": _w((lambda *s: torch.randn(*s, dtype=torch.bfloat16) * 0.05)(D, D)),
        "b": _w((lambda *s: torch.randn(*s, dtype=torch.bfloat16) * 0.05)(D)),
    }

def reference(x, w, b):
    B, S, D = x.shape
    N, M = 2, 4
    G = D // M
    wg = w.reshape(G, M, D)
    mag = torch.abs(wg)
    order = torch.argsort(mag, 1)
    thr = (lambda x, i, axis: torch.take_along_dim(x, i, dim=axis))(mag, order[:, M - N:M - N + 1, :], 1)
    mask = (lambda x, dt: x.to(dt))(mag >= thr, w.dtype)
    wp = (wg * mask).reshape(D, D)
    return torch.einsum("bsd,df->bsf", x, wp) + b
```

```asm
; @launch grid=(256,1,1) block=(256,1,1) lds=151312
.amdgcn_target "amdgcn-amd-amdhsa--gfx950"
.text
    .globl standalone__structured_sparse_n_m__ragged_kernel
    .p2align 8
    .type standalone__structured_sparse_n_m__ragged_kernel,@function
standalone__structured_sparse_n_m__ragged_kernel:
    s_cmp_ge_u32 s2, 256
    s_cbranch_scc1 L_main_end
    s_load_dwordx4 s[4:7], s[0:1], 0
    s_load_dwordx4 s[8:11], s[0:1], 16
    s_load_dwordx4 s[72:75], s[0:1], 32
    v_lshrrev_b32 v6, 6, v0
    s_nop 0
    v_readfirstlane_b32 s24, v6
    s_and_b32 s25, s2, 7
    s_lshr_b32 s26, s2, 3
    s_and_b32 s27, s26, 3
    s_lshr_b32 s26, s26, 2
    s_lshl_b32 s25, s25, 3
    s_add_u32 s26, s26, s25
    s_lshl_b32 s28, s27, 2
    s_add_u32 s28, s28, s24
    s_lshr_b32 s87, s2, 1
    s_and_b32 s88, s2, 1
    s_mov_b32 s95, 0
    s_waitcnt lgkmcnt(0)
    s_mov_b32 s12, s4
    s_and_b32 s13, s5, 0xffff
    s_mov_b32 s14, 0x2000000
    s_mov_b32 s15, 0x00020000
    s_mov_b32 s16, s10
    s_and_b32 s17, s11, 0xffff
    s_mov_b32 s18, 0x2000000
    s_mov_b32 s19, 0x00020000
    s_mov_b32 s20, s74
    s_and_b32 s21, s75, 0xffff
    s_mov_b32 s22, 0x10000000
    s_mov_b32 s23, 0x00020000
    s_mov_b32 s44, s8
    s_and_b32 s45, s9, 0xffff
    s_mov_b32 s46, 0x800
    s_mov_b32 s47, 0x00020000
    s_mov_b32 s68, s6
    s_and_b32 s69, s7, 0xffff
    s_mov_b32 s70, 0x200000
    s_mov_b32 s71, 0x00020000
    s_and_b32 s73, s73, 0xffff
    s_mov_b32 s74, 0x100
    s_mov_b32 s75, 0x00020000
    v_mov_b32 v245, 0
    v_mov_b32 v246, 1
    v_and_b32 v3, 63, v0
    v_lshlrev_b32 v5, 6, v3
    v_lshlrev_b32 v3, 4, v3
    s_lshl_b32 s37, s26, 19
    s_lshl_b32 s36, s2, 2
    s_add_u32 s36, s36, s24
    s_cmp_lg_u32 s36, 3
    s_cbranch_scc1 L_no_nonce
    s_memrealtime s[90:91]
    s_waitcnt lgkmcnt(0)
    s_or_b32 s90, s90, 1
    v_mov_b32 v247, s90
    v_cmp_eq_u32 vcc, 0, v3
    s_and_saveexec_b64 s[66:67], vcc
    buffer_store_dword v247, v245, s[72:75], 0 offen sc1
    s_mov_b64 exec, s[66:67]
L_no_nonce:
    v_mov_b32 v40, 0
    v_mov_b32 v41, 0
    v_mov_b32 v241, 0
    v_mov_b32 v4, 0
    v_mov_b32 v252, v0
    s_cmp_ge_u32 s2, 128
    s_cbranch_scc1 L_setup
L_prep_again:
    v_mov_b32 v0, v252
    v_lshlrev_b32 v67, 2, v0
    s_lshl_b32 s89, s87, 15
    s_lshl_b32 s90, s88, 10
    s_add_u32 s89, s89, s90
    buffer_load_dword v72, v67, s[68:71], s89 offen
    buffer_load_dword v73, v67, s[68:71], s89 offen offset:2048
    s_add_u32 s89, s89, 4096
    buffer_load_dword v74, v67, s[68:71], s89 offen
    buffer_load_dword v75, v67, s[68:71], s89 offen offset:2048
    s_add_u32 s89, s89, 4096
    buffer_load_dword v76, v67, s[68:71], s89 offen
    buffer_load_dword v77, v67, s[68:71], s89 offen offset:2048
    s_add_u32 s89, s89, 4096
    buffer_load_dword v78, v67, s[68:71], s89 offen
    buffer_load_dword v79, v67, s[68:71], s89 offen offset:2048
    s_add_u32 s89, s89, 4096
    buffer_load_dword v80, v67, s[68:71], s89 offen
    buffer_load_dword v81, v67, s[68:71], s89 offen offset:2048
    s_add_u32 s89, s89, 4096
    buffer_load_dword v82, v67, s[68:71], s89 offen
    buffer_load_dword v83, v67, s[68:71], s89 offen offset:2048
    s_add_u32 s89, s89, 4096
    buffer_load_dword v84, v67, s[68:71], s89 offen
    buffer_load_dword v85, v67, s[68:71], s89 offen offset:2048
    s_add_u32 s89, s89, 4096
    buffer_load_dword v86, v67, s[68:71], s89 offen
    buffer_load_dword v87, v67, s[68:71], s89 offen offset:2048
    s_mov_b32 s76, 0x7fff7fff
    s_mov_b32 s77, 0x00010001
    s_mov_b32 s78, 0x000f000f
    s_mov_b32 s80, 0x49884444
    s_mov_b32 s81, 0x498e4dcc
    s_mov_b32 s82, 0xe8804000
    s_mov_b32 s83, 0x05040100
    s_mov_b32 s84, 0x07060302
    s_mov_b32 s85, 0x01000100
    s_mov_b32 s86, 0x0202
    v_and_b32 v65, 15, v0
    v_lshrrev_b32 v66, 4, v0
    s_lshl_b32 s90, s88, 4
    v_add_u32 v66, s90, v66
    v_and_b32 v68, 9, v65
    v_bfe_u32 v69, v65, 1, 1
    v_bfe_u32 v70, v65, 2, 1
    v_lshl_or_b32 v68, v69, 2, v68
    v_lshl_or_b32 v68, v70, 1, v68
    v_lshlrev_b32 v68, 1, v68
    v_lshlrev_b32 v88, 15, v66
    v_lshl_add_u32 v88, v68, 4, v88
    v_lshlrev_b32 v89, 12, v66
    v_lshl_add_u32 v89, v68, 4, v89
    s_lshr_b32 s91, s87, 1
    s_and_b32 s92, s87, 1
    s_lshl_b32 s93, s91, 10
    s_lshl_b32 s92, s92, 9
    s_add_u32 s93, s93, s92
    s_add_u32 s93, s93, 0x40000
    s_lshr_b32 s94, s91, 3
    s_lshl_b32 s94, s94, 10
    s_add_u32 s94, s94, s92
    s_and_b32 s91, s91, 7
    s_lshl_b32 s91, s91, 1
    s_add_u32 s94, s94, s91
    s_add_u32 s94, s94, 0x4000
    v_mov_b32 v100, 0
    v_mov_b32 v101, 0
    v_mov_b32 v102, 0
    s_mov_b32 s89, 0
    s_waitcnt vmcnt(0)
L_pg:
    s_set_gpr_idx_on s89, 0x1
    s_nop 0
    v_mov_b32 v114, v72
    v_mov_b32 v115, v73
    v_mov_b32 v116, v74
    v_mov_b32 v117, v75
    s_set_gpr_idx_off
    v_and_b32 v104, s76, v114
    v_and_b32 v105, s76, v115
    v_and_b32 v106, s76, v116
    v_and_b32 v107, s76, v117
    v_pk_max_u16 v108, v104, v105
    v_pk_min_u16 v109, v104, v105
    v_pk_max_u16 v110, v106, v107
    v_pk_min_u16 v111, v106, v107
    v_pk_min_u16 v108, v108, v110
    v_pk_max_u16 v109, v109, v111
    v_pk_max_u16 v108, v108, v109
    v_pk_max_u16 v108, v108, s77
    v_pk_sub_u16 v104, v108, v104 clamp
    v_pk_sub_u16 v105, v108, v105 clamp
    v_pk_sub_u16 v106, v108, v106 clamp
    v_pk_sub_u16 v107, v108, v107 clamp
    v_pk_min_u16 v104, v104, s77
    v_pk_min_u16 v105, v105, s77
    v_pk_min_u16 v106, v106, s77
    v_pk_min_u16 v107, v107, s77
    v_lshl_or_b32 v104, v105, 1, v104
    v_lshl_or_b32 v104, v106, 2, v104
    v_lshl_or_b32 v104, v107, 3, v104
    v_xor_b32 v104, s78, v104
    s_lshr_b32 s90, s89, 2
    v_bfe_u32 v105, v104, 0, 4
    v_lshlrev_b32 v106, 2, v105
    v_lshrrev_b64 v[110:111], v106, s[80:81]
    v_and_b32 v110, 15, v110
    v_lshl_or_b32 v100, v110, s89, v100
    v_perm_b32 v112, v115, v114, s83
    v_perm_b32 v113, v117, v116, s83
    v_and_b32 v111, 3, v110
    v_lshrrev_b32 v110, 2, v110
    v_lshl_or_b32 v110, v110, 16, v111
    v_mov_b32 v111, s85
    v_mad_u32_u24 v110, v110, s86, v111
    v_perm_b32 v118, v113, v112, v110
    v_lshlrev_b32 v106, 1, v105
    v_lshrrev_b32 v107, v106, s82
    v_and_b32 v107, 3, v107
    v_lshl_or_b32 v102, v107, s89, v102
    v_bfe_u32 v105, v104, 16, 4
    v_lshlrev_b32 v106, 2, v105
    v_lshrrev_b64 v[110:111], v106, s[80:81]
    v_and_b32 v110, 15, v110
    v_lshl_or_b32 v101, v110, s89, v101
    v_perm_b32 v112, v115, v114, s84
    v_perm_b32 v113, v117, v116, s84
    v_and_b32 v111, 3, v110
    v_lshrrev_b32 v110, 2, v110
    v_lshl_or_b32 v110, v110, 16, v111
    v_mov_b32 v111, s85
    v_mad_u32_u24 v110, v110, s86, v111
    v_perm_b32 v119, v113, v112, v110
    v_lshlrev_b32 v106, 1, v105
    v_lshrrev_b32 v107, v106, s82
    v_and_b32 v107, 3, v107
    v_lshlrev_b32 v107, 2, v107
    v_lshl_or_b32 v102, v107, s89, v102
    s_set_gpr_idx_on s90, 0x8
    s_nop 0
    v_mov_b32 v92, v118
    v_mov_b32 v96, v119
    s_set_gpr_idx_off
    s_add_u32 s89, s89, 4
    s_cmp_lt_u32 s89, 16
    s_cbranch_scc1 L_pg
    buffer_store_dwordx4 v[92:95], v88, s[20:23], s93 offen sc1
    buffer_store_dwordx4 v[96:99], v88, s[20:23], s93 offen offset:16 sc1
    buffer_store_short v100, v89, s[20:23], s94 offen sc1
    buffer_store_short v101, v89, s[20:23], s94 offen offset:16 sc1
    v_bcnt_u32_b32 v103, v102, 0
    v_mov_b32 v104, v103
    s_nop 1
    v_add_u32_dpp v104, v104, v104 row_shr:1 row_mask:0xf bank_mask:0xf bound_ctrl:0
    s_nop 1
    v_add_u32_dpp v104, v104, v104 row_shr:2 row_mask:0xf bank_mask:0xf bound_ctrl:0
    s_nop 1
    v_add_u32_dpp v104, v104, v104 row_shr:4 row_mask:0xf bank_mask:0xf bound_ctrl:0
    s_nop 1
    v_add_u32_dpp v104, v104, v104 row_shr:8 row_mask:0xf bank_mask:0xf bound_ctrl:0
    s_nop 1
    v_lshlrev_b32 v105, 8, v66
    s_lshl_b32 s89, s87, 2
    v_cmp_eq_u32 vcc, 15, v65
    s_and_saveexec_b64 s[66:67], vcc
    buffer_store_dword v104, v105, s[20:23], s89 offen offset:0 sc1
    s_mov_b64 exec, s[66:67]
    v_sub_u32 v104, v104, v103
    v_lshlrev_b32 v105, 16, v66
    s_lshl_b32 s93, s87, 10
    s_add_u32 s93, s93, 0x200000
    s_mov_b32 s89, 0
L_pe:
    v_cmp_ne_u32 vcc, 0, v102
    s_cbranch_vccz L_pe_done
    v_and_b32 v106, 1, v102
    v_cmp_ne_u32 vcc, 0, v106
    s_and_saveexec_b64 s[66:67], vcc
    s_cbranch_execz L_pe_next
    s_and_b32 s90, s89, 12
    s_and_b32 s91, s89, 1
    s_add_u32 s92, s90, s91
    s_set_gpr_idx_on s92, 0x1
    s_nop 0
    v_mov_b32 v107, v74
    s_set_gpr_idx_off
    s_bfe_u32 s92, s89, 0x10001
    s_lshl_b32 s94, s92, 4
    v_lshrrev_b32 v107, s94, v107
    v_and_b32 v107, 0xffff, v107
    s_lshl_b32 s94, s87, 18
    s_lshl_b32 s90, s90, 14
    s_add_u32 s94, s94, s90
    s_add_u32 s91, s91, 2
    s_lshl_b32 s91, s91, 24
    s_add_u32 s94, s94, s91
    s_lshl_b32 s92, s92, 26
    s_add_u32 s94, s94, s92
    v_or_b32 v107, s94, v107
    v_lshl_add_u32 v107, v68, 26, v107
    v_lshl_add_u32 v106, v104, 2, v105
    buffer_store_dword v107, v106, s[20:23], s93 offen sc1
    v_add_u32 v104, 1, v104
L_pe_next:
    s_mov_b64 exec, s[66:67]
    v_lshrrev_b32 v102, 1, v102
    s_add_u32 s89, s89, 1
    s_branch L_pe
L_pe_done:
    s_cmp_eq_u32 s95, 0
    s_cbranch_scc1 L_prep_signal0
    s_add_u32 s87, s87, 1
    s_cmp_lt_u32 s87, 64
    s_cbranch_scc1 L_prep_again
    v_mov_b32 v0, v253
    s_waitcnt vmcnt(0)
    s_barrier
    s_branch L_sync_done
L_prep_signal0:
L_setup:
    v_and_b32 v236, 63, v0
    v_lshlrev_b32 v40, 2, v236
    v_lshlrev_b32 v41, 10, v236
    v_lshlrev_b32 v3, 4, v236
    v_and_b32 v237, 31, v0
    v_bfe_u32 v238, v0, 5, 1
    v_and_b32 v241, 0x13, v237
    v_bfe_u32 v240, v237, 2, 1
    v_lshl_or_b32 v241, v240, 3, v241
    v_bfe_u32 v240, v237, 3, 1
    v_lshl_or_b32 v241, v240, 2, v241
    v_lshlrev_b32 v241, 1, v241
    v_mul_u32_u24 v2, 4144, v237
    v_lshl_add_u32 v1, v238, 4, v2
    v_lshrrev_b32 v242, 3, v236
    v_and_b32 v243, 7, v236
    v_lshlrev_b32 v4, 11, v242
    v_lshl_add_u32 v4, v243, 4, v4
    s_mul_i32 s38, s24, 4608
    s_add_u32 s38, s38, 132608
    v_mul_u32_u24 v6, 144, v242
    v_lshl_add_u32 v6, v243, 4, v6
    v_add_u32 v6, s38, v6
    v_mul_u32_u24 v0, 144, v237
    v_lshl_add_u32 v0, v238, 4, v0
    v_add_u32 v0, s38, v0
    v_mov_b32 v253, v0
    v_lshlrev_b32 v5, 6, v236
    v_lshlrev_b32 v239, 3, v238
    s_mul_i32 s35, s24, 33152
    s_add_u32 s36, s35, 2064
    v_add_u32 v42, s36, v3
    v_add_u32 v43, s38, v3
    v_mov_b32 v68, 0
    v_mov_b32 v69, 0
    v_mov_b32 v70, 0
    v_mov_b32 v71, 0
    v_mov_b32 v72, 0x8000800
    v_add_u32 v73, s38, v40
    ds_write_b128 v42, v[68:71] offset:0
    ds_write_b128 v42, v[68:71] offset:1024
    ds_write_b128 v42, v[68:71] offset:4144
    ds_write_b128 v42, v[68:71] offset:5168
    ds_write_b128 v42, v[68:71] offset:8288
    ds_write_b128 v42, v[68:71] offset:9312
    ds_write_b128 v42, v[68:71] offset:12432
    ds_write_b128 v42, v[68:71] offset:13456
    ds_write_b128 v43, v[68:71] offset:0
    ds_write_b128 v42, v[68:71] offset:16576
    ds_write_b128 v42, v[68:71] offset:17600
    ds_write_b128 v42, v[68:71] offset:20720
    ds_write_b128 v42, v[68:71] offset:21744
    ds_write_b128 v42, v[68:71] offset:24864
    ds_write_b128 v42, v[68:71] offset:25888
    ds_write_b128 v42, v[68:71] offset:29008
    ds_write_b128 v42, v[68:71] offset:30032
    ds_write_b128 v43, v[68:71] offset:1024
    ds_write_b32 v73, v72 offset:2048
    v_mov_b32 v242, 0x3f803f80
    v_mov_b32 v243, 0x3f803f80
    ds_write_b64 v2, v[242:243] offset:2048
    ds_write_b64 v2, v[242:243] offset:4112
    s_cmp_ge_u32 s2, 128
    s_cbranch_scc1 L_prep_skip
    buffer_load_dword v247, v245, s[72:75], 0 offen sc1
    s_waitcnt vmcnt(0)
    s_barrier
    s_cmp_lg_u32 s24, 0
    s_cbranch_scc1 L_x0
    s_mov_b32 s38, 1
    s_memrealtime s[90:91]
    s_branch L_nonce_chk
L_prep_skip:
    s_cmp_lg_u32 s24, 0
    s_cbranch_scc1 L_x0
    s_mov_b32 s38, 0
    s_memrealtime s[90:91]
    s_sleep 64
L_nonce_poll:
    buffer_load_dword v247, v245, s[72:75], 0 offen sc1
    s_waitcnt vmcnt(0)
L_nonce_chk:
    v_readfirstlane_b32 s89, v247
    s_memrealtime s[92:93]
    s_waitcnt lgkmcnt(0)
    s_sub_u32 s92, s92, s90
    s_cmp_lg_u32 s89, 0
    s_cbranch_scc1 L_nonce_ok
    s_sleep 8
    s_cmp_lt_u32 s92, 20000
    s_cbranch_scc1 L_nonce_poll
    s_branch L_poll_fail
L_nonce_ok:
    s_cmp_eq_u32 s38, 0
    s_cbranch_scc1 L_poll_setup
    s_lshl_b32 s36, s88, 6
    s_add_u32 s36, s36, s87
    s_lshl_b32 s36, s36, 7
    s_add_u32 s36, s36, 0x400000
    v_cmp_eq_u32 vcc, 0, v3
    s_and_saveexec_b64 s[66:67], vcc
    buffer_store_dword v247, v245, s[20:23], s36 offen sc1
    s_mov_b64 exec, s[66:67]
L_poll_setup:
    s_lshr_b32 s36, s27, 1
    s_lshl_b32 s36, s36, 13
    s_add_u32 s36, s36, 0x400000
    v_lshlrev_b32 v248, 3, v3
L_poll:
    buffer_load_dword v247, v248, s[20:23], s36 offen sc1
    s_memrealtime s[92:93]
    s_waitcnt vmcnt(0) lgkmcnt(0)
    v_cmp_ne_u32 vcc, s89, v247
    s_sub_u32 s92, s92, s90
    s_cmp_eq_u64 vcc, 0
    s_cbranch_scc1 L_poll_ok
    s_sleep 8
    s_cmp_lt_u32 s92, 20000
    s_cbranch_scc1 L_poll
L_poll_fail:
    v_mov_b32 v245, 1
L_poll_ok:
    v_mov_b32 v246, 151296
    ds_write_b32 v246, v245
    s_waitcnt lgkmcnt(0)
    s_branch L_sync_wait
L_x0:
    s_sub_u32 s36, s24, 1
    s_mul_i32 s38, s36, 11
    s_add_u32 s39, s38, 11
    s_min_u32 s39, s39, 32
L_x0_loop1:
    s_mul_i32 s40, s38, 4144
    s_mov_b32 m0, s40
    s_lshl_b32 s40, s38, 11
    s_add_u32 s40, s40, s37
    buffer_load_dwordx4 v3, s[12:15], s40 offen lds
    buffer_load_dwordx4 v3, s[12:15], s40 offen offset:1024 lds
    s_add_u32 s38, s38, 1
    s_cmp_lt_u32 s38, s39
    s_cbranch_scc1 L_x0_loop1
L_x0_done:
    s_mov_b32 m0, 151040
    s_lshl_b32 s40, s27, 14
    s_add_u32 s40, s40, s37
    s_lshl_b32 s38, s36, 12
    s_add_u32 s40, s40, s38
    s_add_u32 s38, s40, 65536
    buffer_load_dword v5, s[12:15], s38 offen lds
    s_add_u32 s38, s40, 69632
    buffer_load_dword v5, s[12:15], s38 offen lds
L_sync_wait:
    s_barrier
    v_mov_b32 v246, 151296
    ds_read_b32 v245, v246
    s_waitcnt lgkmcnt(0)
    v_readfirstlane_b32 s95, v245
    s_mov_b32 s87, 0
    s_lshr_b32 s88, s27, 1
    s_cmp_lg_u32 s95, 0
    s_cbranch_scc1 L_prep_again
L_sync_done:
    s_mul_i32 s38, s24, 4608
    s_add_u32 s38, s38, 132608
    s_lshl_b32 s36, s28, 9
    s_add_u32 s36, s36, 0x0
    buffer_load_dword v44, v40, s[20:23], s36 offen sc1
    s_lshl_b32 s36, s28, 17
    s_add_u32 s36, s36, 0x200000
    buffer_load_dwordx4 v[48:51], v41, s[20:23], s36 offen sc1
    buffer_load_dwordx4 v[52:55], v41, s[20:23], s36 offen offset:16 sc1
    s_lshl_b32 s36, s28, 9
    s_add_u32 s36, s36, 0x100
    buffer_load_dword v56, v40, s[20:23], s36 offen sc1
    s_lshl_b32 s36, s28, 17
    s_add_u32 s36, s36, 0x210000
    buffer_load_dwordx4 v[60:63], v41, s[20:23], s36 offen sc1
    buffer_load_dwordx4 v[64:67], v41, s[20:23], s36 offen offset:16 sc1
    s_lshl_b32 s36, s28, 7
    buffer_load_ushort v120, v241, s[44:47], s36 offen
    buffer_load_ushort v124, v241, s[44:47], s36 offen offset:64
    s_lshl_b32 s36, s28, 13
    s_add_u32 s36, s36, 0x4000
    buffer_load_dwordx4 v[8:11], v3, s[20:23], s36 offen offset:0 sc1
    buffer_load_dwordx4 v[12:15], v3, s[20:23], s36 offen offset:1024 sc1
    buffer_load_dwordx4 v[16:19], v3, s[20:23], s36 offen offset:2048 sc1
    buffer_load_dwordx4 v[20:23], v3, s[20:23], s36 offen offset:3072 sc1
    s_add_u32 s36, s36, 0x1000
    buffer_load_dwordx4 v[24:27], v3, s[20:23], s36 offen offset:0 sc1
    buffer_load_dwordx4 v[28:31], v3, s[20:23], s36 offen offset:1024 sc1
    buffer_load_dwordx4 v[32:35], v3, s[20:23], s36 offen offset:2048 sc1
    buffer_load_dwordx4 v[36:39], v3, s[20:23], s36 offen offset:3072 sc1
    s_lshl_b32 s42, s28, 16
    s_add_u32 s42, s42, 0x40000
    s_add_u32 s43, s42, 0x8000
    buffer_load_dwordx4 a[0:3], v3, s[20:23], s42 offen offset:0 sc1
    buffer_load_dwordx4 a[4:7], v3, s[20:23], s43 offen offset:0 sc1
    buffer_load_dwordx4 a[8:11], v3, s[20:23], s42 offen offset:1024 sc1
    buffer_load_dwordx4 a[12:15], v3, s[20:23], s43 offen offset:1024 sc1
    buffer_load_dwordx4 a[16:19], v3, s[20:23], s42 offen offset:2048 sc1
    buffer_load_dwordx4 a[20:23], v3, s[20:23], s43 offen offset:2048 sc1
    buffer_load_dwordx4 a[24:27], v3, s[20:23], s42 offen offset:3072 sc1
    buffer_load_dwordx4 a[28:31], v3, s[20:23], s43 offen offset:3072 sc1
    s_add_u32 s42, s42, 0x1000
    s_add_u32 s43, s43, 0x1000
    buffer_load_dwordx4 a[32:35], v3, s[20:23], s42 offen offset:0 sc1
    buffer_load_dwordx4 a[36:39], v3, s[20:23], s43 offen offset:0 sc1
    buffer_load_dwordx4 a[40:43], v3, s[20:23], s42 offen offset:1024 sc1
    buffer_load_dwordx4 a[44:47], v3, s[20:23], s43 offen offset:1024 sc1
    buffer_load_dwordx4 a[48:51], v3, s[20:23], s42 offen offset:2048 sc1
    buffer_load_dwordx4 a[52:55], v3, s[20:23], s43 offen offset:2048 sc1
    buffer_load_dwordx4 a[56:59], v3, s[20:23], s42 offen offset:3072 sc1
    buffer_load_dwordx4 a[60:63], v3, s[20:23], s43 offen offset:3072 sc1
    s_add_u32 s42, s42, 0x1000
    s_add_u32 s43, s43, 0x1000
    buffer_load_dwordx4 a[64:67], v3, s[20:23], s42 offen offset:0 sc1
    buffer_load_dwordx4 a[68:71], v3, s[20:23], s43 offen offset:0 sc1
    buffer_load_dwordx4 a[72:75], v3, s[20:23], s42 offen offset:1024 sc1
    buffer_load_dwordx4 a[76:79], v3, s[20:23], s43 offen offset:1024 sc1
    buffer_load_dwordx4 a[80:83], v3, s[20:23], s42 offen offset:2048 sc1
    buffer_load_dwordx4 a[84:87], v3, s[20:23], s43 offen offset:2048 sc1
    buffer_load_dwordx4 a[88:91], v3, s[20:23], s42 offen offset:3072 sc1
    buffer_load_dwordx4 a[92:95], v3, s[20:23], s43 offen offset:3072 sc1
    s_waitcnt vmcnt(34)
    s_mov_b32 s58, 0
    s_add_u32 s59, s35, 2064
    s_mov_b32 s60, s38
    s_add_u32 s61, s38, 2048
L_bj:
    s_set_gpr_idx_on s58, 0x1
    s_nop 0
    v_mov_b32 v74, v44
    s_set_gpr_idx_off
    v_mov_b32 v75, v74
    v_cmp_lt_u32 vcc, 8, v74
    s_nop 0
    v_add_u32_dpp v75, v75, v75 row_shr:1 row_mask:0xf bank_mask:0xf bound_ctrl:0
    s_nop 0
    s_nop 0
    v_add_u32_dpp v75, v75, v75 row_shr:2 row_mask:0xf bank_mask:0xf bound_ctrl:0
    s_nop 0
    s_nop 0
    v_add_u32_dpp v75, v75, v75 row_shr:4 row_mask:0xf bank_mask:0xf bound_ctrl:0
    s_nop 0
    s_nop 0
    v_add_u32_dpp v75, v75, v75 row_shr:8 row_mask:0xf bank_mask:0xf bound_ctrl:0
    s_nop 0
    s_nop 0
    v_add_u32_dpp v75, v75, v75 row_bcast:15 row_mask:0xa bank_mask:0xf
    s_nop 1
    v_add_u32_dpp v75, v75, v75 row_bcast:31 row_mask:0xc bank_mask:0xf
    s_nop 1
    v_readlane_b32 s36, v75, 63
    v_sub_u32 v75, v75, v74
    s_cmp_lg_u64 vcc, 0
    s_cselect_b32 s62, 1, 0
    s_cmp_gt_u32 s36, 64
    s_cselect_b32 s62, 1, s62
    s_add_u32 s36, s36, 7
    s_lshr_b32 s36, s36, 3
    s_cmp_eq_u32 s62, 0
    s_cselect_b32 s36, s36, 0
    s_cmp_eq_u32 s58, 0
    s_cselect_b32 s30, s36, s30
    s_cselect_b32 s64, s62, s64
    s_mov_b32 s31, s36
    s_mov_b32 s65, s62
    s_cmp_lg_u32 s62, 0
    s_cbranch_scc1 L_bj_next
    s_mov_b32 s63, 0
L_be:
    v_cmp_lt_u32 vcc, s63, v74
    s_and_saveexec_b64 s[66:67], vcc
    s_cbranch_execz L_be_done
    s_add_u32 s36, s58, s63
    s_set_gpr_idx_on s36, 0x1
    s_nop 0
    v_mov_b32 v76, v48
    s_set_gpr_idx_off
    v_add_u32 v77, s63, v75
    v_lshrrev_b32 v78, 3, v77
    v_bfe_u32 v79, v77, 2, 1
    v_and_b32 v80, 3, v77
    v_lshrrev_b32 v81, 26, v76
    v_lshl_add_u32 v81, v79, 5, v81
    v_lshlrev_b32 v81, 4, v81
    v_lshrrev_b32 v82, 1, v78
    v_and_b32 v83, 1, v78
    v_mul_u32_u24 v84, 4144, v82
    v_lshl_add_u32 v84, v83, 10, v84
    v_add3_u32 v84, v84, v81, s59
    v_lshl_add_u32 v84, v80, 2, v84
    ds_write_b16 v84, v76
    v_lshl_add_u32 v85, v82, 2, v81
    v_add_u32 v85, s60, v85
    v_lshlrev_b32 v86, 4, v83
    v_lshl_add_u32 v86, v80, 2, v86
    v_bfe_u32 v87, v76, 24, 2
    v_lshlrev_b32 v87, v86, v87
    ds_or_b32 v85, v87
    v_lshlrev_b32 v85, 4, v78
    v_bfe_u32 v86, v77, 1, 1
    v_lshl_add_u32 v85, v86, 3, v85
    v_lshl_add_u32 v85, v79, 2, v85
    v_and_b32 v86, 1, v77
    v_lshl_add_u32 v85, v86, 1, v85
    v_add_u32 v85, s61, v85
    v_bfe_u32 v87, v76, 16, 8
    v_lshlrev_b32 v87, 3, v87
    ds_write_b16 v85, v87
    s_mov_b64 exec, s[66:67]
    s_add_u32 s63, s63, 1
    s_cmp_lt_u32 s63, 8
    s_cbranch_scc1 L_be
L_be_done:
    s_mov_b64 exec, s[66:67]
L_bj_next:
    s_add_u32 s58, s58, 12
    s_add_u32 s59, s59, 16576
    s_add_u32 s60, s60, 1024
    s_add_u32 s61, s61, 128
    s_cmp_lt_u32 s58, 24
    s_cbranch_scc1 L_bj
    v_add_u32 v73, s38, v239
    ds_read_b128 v[132:135], v42 offset:0
    ds_read_b64 v[204:205], v73 offset:2048
    ds_read_b128 v[136:139], v42 offset:1024
    ds_read_b64 v[206:207], v73 offset:2064
    ds_read_b128 v[140:143], v42 offset:4144
    ds_read_b64 v[208:209], v73 offset:2080
    ds_read_b128 v[144:147], v42 offset:5168
    ds_read_b64 v[210:211], v73 offset:2096
    ds_read_b128 v[148:151], v42 offset:8288
    ds_read_b64 v[212:213], v73 offset:2112
    ds_read_b128 v[152:155], v42 offset:9312
    ds_read_b64 v[214:215], v73 offset:2128
    ds_read_b128 v[156:159], v42 offset:12432
    ds_read_b64 v[216:217], v73 offset:2144
    ds_read_b128 v[160:163], v42 offset:13456
    ds_read_b64 v[218:219], v73 offset:2160
    ds_read_b128 v[196:199], v43 offset:0
    ds_read_b128 v[164:167], v42 offset:16576
    ds_read_b64 v[220:221], v73 offset:2176
    ds_read_b128 v[168:171], v42 offset:17600
    ds_read_b64 v[222:223], v73 offset:2192
    ds_read_b128 v[172:175], v42 offset:20720
    ds_read_b64 v[224:225], v73 offset:2208
    ds_read_b128 v[176:179], v42 offset:21744
    ds_read_b64 v[226:227], v73 offset:2224
    ds_read_b128 v[180:183], v42 offset:24864
    ds_read_b64 v[228:229], v73 offset:2240
    ds_read_b128 v[184:187], v42 offset:25888
    ds_read_b64 v[230:231], v73 offset:2256
    ds_read_b128 v[188:191], v42 offset:29008
    ds_read_b64 v[232:233], v73 offset:2272
    ds_read_b128 v[192:195], v42 offset:30032
    ds_read_b64 v[234:235], v73 offset:2288
    ds_read_b128 v[200:203], v43 offset:1024
    s_add_u32 s42, s42, 0x1000
    s_add_u32 s43, s43, 0x1000
    buffer_load_dwordx4 a[96:99], v3, s[20:23], s42 offen offset:0 sc1
    buffer_load_dwordx4 a[100:103], v3, s[20:23], s43 offen offset:0 sc1
    buffer_load_dwordx4 a[104:107], v3, s[20:23], s42 offen offset:1024 sc1
    buffer_load_dwordx4 a[108:111], v3, s[20:23], s43 offen offset:1024 sc1
    buffer_load_dwordx4 a[112:115], v3, s[20:23], s42 offen offset:2048 sc1
    buffer_load_dwordx4 a[116:119], v3, s[20:23], s43 offen offset:2048 sc1
    buffer_load_dwordx4 a[120:123], v3, s[20:23], s42 offen offset:3072 sc1
    buffer_load_dwordx4 a[124:127], v3, s[20:23], s43 offen offset:3072 sc1
    s_add_u32 s42, s42, 0x1000
    s_add_u32 s43, s43, 0x1000
    buffer_load_dwordx4 a[128:131], v3, s[20:23], s42 offen offset:0 sc1
    buffer_load_dwordx4 a[132:135], v3, s[20:23], s43 offen offset:0 sc1
    buffer_load_dwordx4 a[136:139], v3, s[20:23], s42 offen offset:1024 sc1
    buffer_load_dwordx4 a[140:143], v3, s[20:23], s43 offen offset:1024 sc1
    buffer_load_dwordx4 a[144:147], v3, s[20:23], s42 offen offset:2048 sc1
    buffer_load_dwordx4 a[148:151], v3, s[20:23], s43 offen offset:2048 sc1
    buffer_load_dwordx4 a[152:155], v3, s[20:23], s42 offen offset:3072 sc1
    buffer_load_dwordx4 a[156:159], v3, s[20:23], s43 offen offset:3072 sc1
    s_add_u32 s42, s42, 0x1000
    s_add_u32 s43, s43, 0x1000
    buffer_load_dwordx4 a[160:163], v3, s[20:23], s42 offen offset:0 sc1
    buffer_load_dwordx4 a[164:167], v3, s[20:23], s43 offen offset:0 sc1
    buffer_load_dwordx4 a[168:171], v3, s[20:23], s42 offen offset:1024 sc1
    buffer_load_dwordx4 a[172:175], v3, s[20:23], s43 offen offset:1024 sc1
    buffer_load_dwordx4 a[176:179], v3, s[20:23], s42 offen offset:2048 sc1
    buffer_load_dwordx4 a[180:183], v3, s[20:23], s43 offen offset:2048 sc1
    buffer_load_dwordx4 a[184:187], v3, s[20:23], s42 offen offset:3072 sc1
    buffer_load_dwordx4 a[188:191], v3, s[20:23], s43 offen offset:3072 sc1
    s_add_u32 s42, s42, 0x1000
    s_add_u32 s43, s43, 0x1000
    buffer_load_dwordx4 a[192:195], v3, s[20:23], s42 offen offset:0 sc1
    buffer_load_dwordx4 a[196:199], v3, s[20:23], s43 offen offset:0 sc1
    buffer_load_dwordx4 a[200:203], v3, s[20:23], s42 offen offset:1024 sc1
    buffer_load_dwordx4 a[204:207], v3, s[20:23], s43 offen offset:1024 sc1
    buffer_load_dwordx4 a[208:211], v3, s[20:23], s42 offen offset:2048 sc1
    buffer_load_dwordx4 a[212:215], v3, s[20:23], s43 offen offset:2048 sc1
    buffer_load_dwordx4 a[216:219], v3, s[20:23], s42 offen offset:3072 sc1
    buffer_load_dwordx4 a[220:223], v3, s[20:23], s43 offen offset:3072 sc1
    s_add_u32 s42, s42, 0x1000
    s_add_u32 s43, s43, 0x1000
    buffer_load_dwordx4 a[224:227], v3, s[20:23], s42 offen offset:0 sc1
    buffer_load_dwordx4 a[228:231], v3, s[20:23], s43 offen offset:0 sc1
    buffer_load_dwordx4 a[232:235], v3, s[20:23], s42 offen offset:1024 sc1
    buffer_load_dwordx4 a[236:239], v3, s[20:23], s43 offen offset:1024 sc1
    buffer_load_dwordx4 a[240:243], v3, s[20:23], s42 offen offset:2048 sc1
    buffer_load_dwordx4 a[244:247], v3, s[20:23], s43 offen offset:2048 sc1
    buffer_load_dwordx4 a[248:251], v3, s[20:23], s42 offen offset:3072 sc1
    buffer_load_dwordx4 a[252:255], v3, s[20:23], s43 offen offset:3072 sc1
    s_lshl_b32 s37, s26, 19
    s_lshl_b32 s33, s24, 14
    s_add_u32 s37, s37, s33
    s_add_u32 s37, s37, 0x10000
    s_lshl_b32 s41, s26, 19
    s_lshl_b32 s33, s27, 14
    s_add_u32 s41, s41, s33
    s_lshl_b32 s33, s24, 12
    s_add_u32 s41, s41, s33
    s_add_u32 s41, s41, 131072
    s_lshl_b32 s33, s26, 19
    s_lshl_b32 s36, s28, 7
    s_add_u32 s33, s33, s36
    s_mov_b32 s34, 0x40000000
    s_mov_b32 s39, 0
    s_mov_b32 s29, 2064
    s_add_u32 s32, s35, 2064
    s_waitcnt vmcnt(63)
    v_cmp_eq_u32 vcc, 0, v238
    v_mov_b32 v121, 0
    v_mov_b32 v122, 0
    v_mov_b32 v123, 0
    v_mov_b32 v125, 0
    v_mov_b32 v126, 0
    v_mov_b32 v127, 0
    v_cndmask_b32 v120, 0, v120, vcc
    v_cndmask_b32 v124, 0, v124, vcc
    v_mov_b32 v128, 0x3f80
    v_mov_b32 v129, 0
    v_mov_b32 v130, 0
    v_mov_b32 v131, 0
    s_waitcnt vmcnt(0) lgkmcnt(0)
    s_barrier
    v_mfma_f32_32x32x16_bf16 v[40:55], v[120:123], v[128:131], 0
    ds_read_b128 v[88:91], v1 offset:0
    ds_read_b128 v[92:95], v1 offset:32
    ds_read_b128 v[96:99], v1 offset:64
    ds_read_b128 v[100:103], v1 offset:96
    ds_read_b128 v[104:107], v1 offset:128
    ds_read_b128 v[108:111], v1 offset:160
L_loop:
    s_cmp_lt_u32 s39, 7
    s_cselect_b32 s40, s37, 0x40000000
    s_cmp_lt_u32 s39, 6
    s_cselect_b32 s42, s41, 0x40000000
    s_waitcnt lgkmcnt(4)
    v_smfmac_f32_32x32x32_bf16 v[40:55], a[0:3], v[88:95], v8
    v_cvt_pk_bf16_f32 v80, v56, v57
    v_cvt_pk_bf16_f32 v81, v58, v59
    v_cvt_pk_bf16_f32 v82, v60, v61
    v_cvt_pk_bf16_f32 v83, v62, v63
    ds_read_b128 v[112:115], v1 offset:192
    s_waitcnt lgkmcnt(3)
    v_smfmac_f32_32x32x32_bf16 v[40:55], a[8:11], v[96:103], v8 abid:1
    v_cvt_pk_bf16_f32 v84, v64, v65
    v_cvt_pk_bf16_f32 v85, v66, v67
    v_cvt_pk_bf16_f32 v86, v68, v69
    v_cvt_pk_bf16_f32 v87, v70, v71
    ds_read_b128 v[116:119], v1 offset:224
    v_mfma_f32_32x32x16_bf16 v[56:71], v[124:127], v[128:131], 0
    v_add_u32_sdwa v236, v2, v204 dst_sel:DWORD dst_unused:UNUSED_PAD src0_sel:DWORD src1_sel:WORD_0
    v_add_u32_sdwa v238, v2, v204 dst_sel:DWORD dst_unused:UNUSED_PAD src0_sel:DWORD src1_sel:WORD_1
    ds_read_b64 v[236:237], v236
    s_add_u32 m0, s32, 0
    s_add_u32 s36, s40, 0
    buffer_load_dwordx4 v3, s[12:15], s36 offen lds
    ds_read_b64 v[238:239], v238
    v_add_u32_sdwa v240, v2, v205 dst_sel:DWORD dst_unused:UNUSED_PAD src0_sel:DWORD src1_sel:WORD_0
    v_smfmac_f32_32x32x32_bf16 v[56:71], a[4:7], v[88:95], v24
    ds_read_b128 v[88:91], v1 offset:256
    ds_read_b64 v[240:241], v240
    v_add_u32_sdwa v242, v2, v205 dst_sel:DWORD dst_unused:UNUSED_PAD src0_sel:DWORD src1_sel:WORD_1
    buffer_load_dwordx4 v3, s[12:15], s36 offen offset:1024 lds
    v_smfmac_f32_32x32x32_bf16 v[56:71], a[12:15], v[96:103], v24 abid:1
    ds_read_b128 v[92:95], v1 offset:288
    ds_read_b64 v[242:243], v242
    v_add_u32_sdwa v244, v2, v220 dst_sel:DWORD dst_unused:UNUSED_PAD src0_sel:DWORD src1_sel:WORD_0
    v_add_u32_sdwa v246, v2, v220 dst_sel:DWORD dst_unused:UNUSED_PAD src0_sel:DWORD src1_sel:WORD_1
    ds_read_b64 v[244:245], v244
    s_waitcnt lgkmcnt(9)
    v_smfmac_f32_32x32x32_bf16 v[40:55], a[16:19], v[104:111], v9
    ds_read_b128 v[96:99], v1 offset:320
    ds_read_b64 v[246:247], v246
    v_add_u32_sdwa v248, v2, v221 dst_sel:DWORD dst_unused:UNUSED_PAD src0_sel:DWORD src1_sel:WORD_0
    s_add_u32 m0, s32, 4144
    s_add_u32 s36, s40, 2048
    buffer_load_dwordx4 v3, s[12:15], s36 offen lds
    v_smfmac_f32_32x32x32_bf16 v[56:71], a[20:23], v[104:111], v25
    ds_read_b128 v[100:103], v1 offset:352
    ds_read_b64 v[248:249], v248
    v_add_u32_sdwa v250, v2, v221 dst_sel:DWORD dst_unused:UNUSED_PAD src0_sel:DWORD src1_sel:WORD_1
    s_waitcnt lgkmcnt(11)
    v_smfmac_f32_32x32x32_bf16 v[40:55], a[24:27], v[112:119], v9 abid:1
    ds_read_b128 v[104:107], v1 offset:384
    s_waitcnt lgkmcnt(6)
    v_smfmac_f32_32x32x32_bf16 v[40:55], v[132:135], v[236:243], v196
    ds_read_b64 v[250:251], v250
    v_add_u32_sdwa v236, v2, v206 dst_sel:DWORD dst_unused:UNUSED_PAD src0_sel:DWORD src1_sel:WORD_0
    v_add_u32_sdwa v238, v2, v206 dst_sel:DWORD dst_unused:UNUSED_PAD src0_sel:DWORD src1_sel:WORD_1
    ds_read_b64 v[236:237], v236
    buffer_load_dwordx4 v3, s[12:15], s36 offen offset:1024 lds
    v_smfmac_f32_32x32x32_bf16 v[56:71], a[28:31], v[112:119], v25 abid:1
    ds_read_b128 v[108:111], v1 offset:416
    ds_read_b64 v[238:239], v238
    v_add_u32_sdwa v240, v2, v207 dst_sel:DWORD dst_unused:UNUSED_PAD src0_sel:DWORD src1_sel:WORD_0
    s_waitcnt lgkmcnt(11)
    v_smfmac_f32_32x32x32_bf16 v[40:55], a[32:35], v[88:95], v10
    ds_read_b128 v[112:115], v1 offset:448
    ds_read_b64 v[240:241], v240
    v_add_u32_sdwa v242, v2, v207 dst_sel:DWORD dst_unused:UNUSED_PAD src0_sel:DWORD src1_sel:WORD_1
    s_add_u32 m0, s32, 8288
    s_add_u32 s36, s40, 4096
    buffer_load_dwordx4 v3, s[12:15], s36 offen lds
    v_smfmac_f32_32x32x32_bf16 v[56:71], a[36:39], v[88:95], v26
    ds_read_b128 v[116:119], v1 offset:480
    s_waitcnt lgkmcnt(6)
    v_smfmac_f32_32x32x32_bf16 v[56:71], v[164:167], v[244:251], v200
    ds_read_b64 v[242:243], v242
    s_waitcnt lgkmcnt(10)
    v_smfmac_f32_32x32x32_bf16 v[40:55], a[40:43], v[96:103], v10 abid:1
    ds_read_b128 v[88:91], v1 offset:512
    v_add_u32_sdwa v244, v2, v222 dst_sel:DWORD dst_unused:UNUSED_PAD src0_sel:DWORD src1_sel:WORD_0
    v_add_u32_sdwa v246, v2, v222 dst_sel:DWORD dst_unused:UNUSED_PAD src0_sel:DWORD src1_sel:WORD_1
    ds_read_b64 v[244:245], v244
    buffer_load_dwordx4 v3, s[12:15], s36 offen offset:1024 lds
    v_smfmac_f32_32x32x32_bf16 v[56:71], a[44:47], v[96:103], v26 abid:1
    ds_read_b128 v[92:95], v1 offset:544
    ds_read_b64 v[246:247], v246
    v_add_u32_sdwa v248, v2, v223 dst_sel:DWORD dst_unused:UNUSED_PAD src0_sel:DWORD src1_sel:WORD_0
    s_waitcnt lgkmcnt(9)
    v_smfmac_f32_32x32x32_bf16 v[40:55], a[48:51], v[104:111], v11
    ds_read_b128 v[96:99], v1 offset:576
    s_waitcnt lgkmcnt(5)
    v_smfmac_f32_32x32x32_bf16 v[40:55], v[136:139], v[236:243], v196 abid:1
    ds_read_b64 v[248:249], v248
    v_add_u32_sdwa v250, v2, v223 dst_sel:DWORD dst_unused:UNUSED_PAD src0_sel:DWORD src1_sel:WORD_1
    s_add_u32 m0, s32, 12432
    s_add_u32 s36, s40, 6144
    buffer_load_dwordx4 v3, s[12:15], s36 offen lds
    v_smfmac_f32_32x32x32_bf16 v[56:71], a[52:55], v[104:111], v27
    ds_read_b128 v[100:103], v1 offset:608
    ds_read_b64 v[250:251], v250
    v_add_u32_sdwa v236, v2, v208 dst_sel:DWORD dst_unused:UNUSED_PAD src0_sel:DWORD src1_sel:WORD_0
    v_add_u32_sdwa v238, v2, v208 dst_sel:DWORD dst_unused:UNUSED_PAD src0_sel:DWORD src1_sel:WORD_1
    ds_read_b64 v[236:237], v236
    s_waitcnt lgkmcnt(10)
    v_smfmac_f32_32x32x32_bf16 v[40:55], a[56:59], v[112:119], v11 abid:1
    ds_read_b128 v[104:107], v1 offset:640
    ds_read_b64 v[238:239], v238
    v_add_u32_sdwa v240, v2, v209 dst_sel:DWORD dst_unused:UNUSED_PAD src0_sel:DWORD src1_sel:WORD_0
    buffer_load_dwordx4 v3, s[12:15], s36 offen offset:1024 lds
    v_smfmac_f32_32x32x32_bf16 v[56:71], a[60:63], v[112:119], v27 abid:1
    ds_read_b128 v[108:111], v1 offset:672
    ds_read_b64 v[240:241], v240
    v_add_u32_sdwa v242, v2, v209 dst_sel:DWORD dst_unused:UNUSED_PAD src0_sel:DWORD src1_sel:WORD_1
    s_waitcnt lgkmcnt(10)
    v_smfmac_f32_32x32x32_bf16 v[40:55], a[64:67], v[88:95], v12
    ds_read_b128 v[112:115], v1 offset:704
    s_waitcnt lgkmcnt(6)
    v_smfmac_f32_32x32x32_bf16 v[56:71], v[168:171], v[244:251], v200 abid:1
    ds_read_b64 v[242:243], v242
    s_add_u32 m0, s32, 16576
    s_add_u32 s36, s40, 8192
    buffer_load_dwordx4 v3, s[12:15], s36 offen lds
    v_smfmac_f32_32x32x32_bf16 v[56:71], a[68:71], v[88:95], v28
    ds_read_b128 v[116:119], v1 offset:736
    v_add_u32_sdwa v244, v2, v224 dst_sel:DWORD dst_unused:UNUSED_PAD src0_sel:DWORD src1_sel:WORD_0
    v_add_u32_sdwa v246, v2, v224 dst_sel:DWORD dst_unused:UNUSED_PAD src0_sel:DWORD src1_sel:WORD_1
    ds_read_b64 v[244:245], v244
    s_waitcnt lgkmcnt(10)
    v_smfmac_f32_32x32x32_bf16 v[40:55], a[72:75], v[96:103], v12 abid:1
    ds_read_b128 v[88:91], v1 offset:768
    ds_read_b64 v[246:247], v246
    v_add_u32_sdwa v248, v2, v225 dst_sel:DWORD dst_unused:UNUSED_PAD src0_sel:DWORD src1_sel:WORD_0
    buffer_load_dwordx4 v3, s[12:15], s36 offen offset:1024 lds
    v_smfmac_f32_32x32x32_bf16 v[56:71], a[76:79], v[96:103], v28 abid:1
    ds_read_b128 v[92:95], v1 offset:800
    s_waitcnt lgkmcnt(5)
    v_smfmac_f32_32x32x32_bf16 v[40:55], v[140:143], v[236:243], v197
    ds_read_b64 v[248:249], v248
    v_add_u32_sdwa v250, v2, v225 dst_sel:DWORD dst_unused:UNUSED_PAD src0_sel:DWORD src1_sel:WORD_1
    s_waitcnt lgkmcnt(9)
    v_smfmac_f32_32x32x32_bf16 v[40:55], a[80:83], v[104:111], v13
    ds_read_b128 v[96:99], v1 offset:832
    ds_read_b64 v[250:251], v250
    v_add_u32_sdwa v236, v2, v210 dst_sel:DWORD dst_unused:UNUSED_PAD src0_sel:DWORD src1_sel:WORD_0
    v_add_u32_sdwa v238, v2, v210 dst_sel:DWORD dst_unused:UNUSED_PAD src0_sel:DWORD src1_sel:WORD_1
    ds_read_b64 v[236:237], v236
    s_add_u32 m0, s32, 20720
    s_add_u32 s36, s40, 10240
    buffer_load_dwordx4 v3, s[12:15], s36 offen lds
    v_smfmac_f32_32x32x32_bf16 v[56:71], a[84:87], v[104:111], v29
    ds_read_b128 v[100:103], v1 offset:864
    ds_read_b64 v[238:239], v238
    v_add_u32_sdwa v240, v2, v211 dst_sel:DWORD dst_unused:UNUSED_PAD src0_sel:DWORD src1_sel:WORD_0
    s_waitcnt lgkmcnt(10)
    v_smfmac_f32_32x32x32_bf16 v[40:55], a[88:91], v[112:119], v13 abid:1
    ds_read_b128 v[104:107], v1 offset:896
    ds_read_b64 v[240:241], v240
    v_add_u32_sdwa v242, v2, v211 dst_sel:DWORD dst_unused:UNUSED_PAD src0_sel:DWORD src1_sel:WORD_1
    buffer_load_dwordx4 v3, s[12:15], s36 offen offset:1024 lds
    v_smfmac_f32_32x32x32_bf16 v[56:71], a[92:95], v[112:119], v29 abid:1
    ds_read_b128 v[108:111], v1 offset:928
    s_waitcnt lgkmcnt(6)
    v_smfmac_f32_32x32x32_bf16 v[56:71], v[172:175], v[244:251], v201
    ds_read_b64 v[242:243], v242
    v_add_u32_sdwa v244, v2, v226 dst_sel:DWORD dst_unused:UNUSED_PAD src0_sel:DWORD src1_sel:WORD_0
    v_add_u32_sdwa v246, v2, v226 dst_sel:DWORD dst_unused:UNUSED_PAD src0_sel:DWORD src1_sel:WORD_1
    ds_read_b64 v[244:245], v244
    s_waitcnt lgkmcnt(11)
    v_smfmac_f32_32x32x32_bf16 v[40:55], a[96:99], v[88:95], v14
    ds_read_b128 v[112:115], v1 offset:960
    ds_read_b64 v[246:247], v246
    v_add_u32_sdwa v248, v2, v227 dst_sel:DWORD dst_unused:UNUSED_PAD src0_sel:DWORD src1_sel:WORD_0
    s_add_u32 m0, s32, 24864
    s_add_u32 s36, s40, 12288
    buffer_load_dwordx4 v3, s[12:15], s36 offen lds
    v_smfmac_f32_32x32x32_bf16 v[56:71], a[100:103], v[88:95], v30
    ds_read_b128 v[116:119], v1 offset:992
    ds_read_b64 v[248:249], v248
    v_add_u32_sdwa v250, v2, v227 dst_sel:DWORD dst_unused:UNUSED_PAD src0_sel:DWORD src1_sel:WORD_1
    s_waitcnt lgkmcnt(10)
    v_smfmac_f32_32x32x32_bf16 v[40:55], a[104:107], v[96:103], v14 abid:1
    ds_read_b128 v[88:91], v1 offset:1024
    s_waitcnt lgkmcnt(6)
    v_smfmac_f32_32x32x32_bf16 v[40:55], v[144:147], v[236:243], v197 abid:1
    ds_read_b64 v[250:251], v250
    buffer_load_dwordx4 v3, s[12:15], s36 offen offset:1024 lds
    v_smfmac_f32_32x32x32_bf16 v[56:71], a[108:111], v[96:103], v30 abid:1
    ds_read_b128 v[92:95], v1 offset:1056
    v_add_u32_sdwa v236, v2, v212 dst_sel:DWORD dst_unused:UNUSED_PAD src0_sel:DWORD src1_sel:WORD_0
    v_add_u32_sdwa v238, v2, v212 dst_sel:DWORD dst_unused:UNUSED_PAD src0_sel:DWORD src1_sel:WORD_1
    ds_read_b64 v[236:237], v236
    s_waitcnt lgkmcnt(10)
    v_smfmac_f32_32x32x32_bf16 v[40:55], a[112:115], v[104:111], v15
    ds_read_b128 v[96:99], v1 offset:1088
    ds_read_b64 v[238:239], v238
    v_add_u32_sdwa v240, v2, v213 dst_sel:DWORD dst_unused:UNUSED_PAD src0_sel:DWORD src1_sel:WORD_0
    s_add_u32 m0, s32, 29008
    s_add_u32 s36, s40, 14336
    buffer_load_dwordx4 v3, s[12:15], s36 offen lds
    v_smfmac_f32_32x32x32_bf16 v[56:71], a[116:119], v[104:111], v31
    ds_read_b128 v[100:103], v1 offset:1120
    s_waitcnt lgkmcnt(5)
    v_smfmac_f32_32x32x32_bf16 v[56:71], v[176:179], v[244:251], v201 abid:1
    ds_read_b64 v[240:241], v240
    v_add_u32_sdwa v242, v2, v213 dst_sel:DWORD dst_unused:UNUSED_PAD src0_sel:DWORD src1_sel:WORD_1
    s_waitcnt lgkmcnt(9)
    v_smfmac_f32_32x32x32_bf16 v[40:55], a[120:123], v[112:119], v15 abid:1
    ds_read_b128 v[104:107], v1 offset:1152
    ds_read_b64 v[242:243], v242
    v_add_u32_sdwa v244, v2, v228 dst_sel:DWORD dst_unused:UNUSED_PAD src0_sel:DWORD src1_sel:WORD_0
    v_add_u32_sdwa v246, v2, v228 dst_sel:DWORD dst_unused:UNUSED_PAD src0_sel:DWORD src1_sel:WORD_1
    ds_read_b64 v[244:245], v244
    buffer_load_dwordx4 v3, s[12:15], s36 offen offset:1024 lds
    v_smfmac_f32_32x32x32_bf16 v[56:71], a[124:127], v[112:119], v31 abid:1
    ds_read_b128 v[108:111], v1 offset:1184
    ds_read_b64 v[246:247], v246
    v_add_u32_sdwa v248, v2, v229 dst_sel:DWORD dst_unused:UNUSED_PAD src0_sel:DWORD src1_sel:WORD_0
    s_waitcnt lgkmcnt(10)
    v_smfmac_f32_32x32x32_bf16 v[40:55], a[128:131], v[88:95], v16
    ds_read_b128 v[112:115], v1 offset:1216
    ds_read_b64 v[248:249], v248
    v_add_u32_sdwa v250, v2, v229 dst_sel:DWORD dst_unused:UNUSED_PAD src0_sel:DWORD src1_sel:WORD_1
    s_mov_b32 m0, 151040
    s_nop 0
    buffer_load_dword v5, s[12:15], s42 offen lds
    v_smfmac_f32_32x32x32_bf16 v[56:71], a[132:135], v[88:95], v32
    ds_read_b128 v[116:119], v1 offset:1248
    s_waitcnt lgkmcnt(6)
    v_smfmac_f32_32x32x32_bf16 v[40:55], v[148:151], v[236:243], v198
    ds_read_b64 v[250:251], v250
    ds_write_b128 v0, v[72:75] offset:0
    s_waitcnt lgkmcnt(11)
    v_smfmac_f32_32x32x32_bf16 v[40:55], a[136:139], v[96:103], v16 abid:1
    ds_read_b128 v[88:91], v1 offset:1280
    v_add_u32_sdwa v236, v2, v214 dst_sel:DWORD dst_unused:UNUSED_PAD src0_sel:DWORD src1_sel:WORD_0
    v_add_u32_sdwa v238, v2, v214 dst_sel:DWORD dst_unused:UNUSED_PAD src0_sel:DWORD src1_sel:WORD_1
    ds_read_b64 v[236:237], v236
    v_smfmac_f32_32x32x32_bf16 v[56:71], a[140:143], v[96:103], v32 abid:1
    ds_read_b128 v[92:95], v1 offset:1312
    ds_read_b64 v[238:239], v238
    v_add_u32_sdwa v240, v2, v215 dst_sel:DWORD dst_unused:UNUSED_PAD src0_sel:DWORD src1_sel:WORD_0
    s_waitcnt lgkmcnt(10)
    v_smfmac_f32_32x32x32_bf16 v[40:55], a[144:147], v[104:111], v17
    ds_read_b128 v[96:99], v1 offset:1344
    s_waitcnt lgkmcnt(6)
    v_smfmac_f32_32x32x32_bf16 v[56:71], v[180:183], v[244:251], v202
    ds_read_b64 v[240:241], v240
    v_add_u32_sdwa v242, v2, v215 dst_sel:DWORD dst_unused:UNUSED_PAD src0_sel:DWORD src1_sel:WORD_1
    ds_write_b128 v0, v[76:79] offset:32
    v_smfmac_f32_32x32x32_bf16 v[56:71], a[148:151], v[104:111], v33
    ds_read_b128 v[100:103], v1 offset:1376
    ds_read_b64 v[242:243], v242
    v_add_u32_sdwa v244, v2, v230 dst_sel:DWORD dst_unused:UNUSED_PAD src0_sel:DWORD src1_sel:WORD_0
    v_add_u32_sdwa v246, v2, v230 dst_sel:DWORD dst_unused:UNUSED_PAD src0_sel:DWORD src1_sel:WORD_1
    ds_read_b64 v[244:245], v244
    s_waitcnt lgkmcnt(12)
    v_smfmac_f32_32x32x32_bf16 v[40:55], a[152:155], v[112:119], v17 abid:1
    ds_read_b128 v[104:107], v1 offset:1408
    ds_read_b64 v[246:247], v246
    v_add_u32_sdwa v248, v2, v231 dst_sel:DWORD dst_unused:UNUSED_PAD src0_sel:DWORD src1_sel:WORD_0
    v_smfmac_f32_32x32x32_bf16 v[56:71], a[156:159], v[112:119], v33 abid:1
    ds_read_b128 v[108:111], v1 offset:1440
    ds_read_b64 v[248:249], v248
    v_add_u32_sdwa v250, v2, v231 dst_sel:DWORD dst_unused:UNUSED_PAD src0_sel:DWORD src1_sel:WORD_1
    ds_write_b128 v0, v[80:83] offset:64
    s_waitcnt lgkmcnt(12)
    v_smfmac_f32_32x32x32_bf16 v[40:55], a[160:163], v[88:95], v18
    ds_read_b128 v[112:115], v1 offset:1472
    s_waitcnt lgkmcnt(7)
    v_smfmac_f32_32x32x32_bf16 v[40:55], v[152:155], v[236:243], v198 abid:1
    ds_read_b64 v[250:251], v250
    s_cmp_le_u32 s30, 6
    s_cbranch_scc1 L_g1
    v_add_u32_sdwa v236, v2, v216 dst_sel:DWORD dst_unused:UNUSED_PAD src0_sel:DWORD src1_sel:WORD_0
    v_add_u32_sdwa v238, v2, v216 dst_sel:DWORD dst_unused:UNUSED_PAD src0_sel:DWORD src1_sel:WORD_1
    v_add_u32_sdwa v240, v2, v217 dst_sel:DWORD dst_unused:UNUSED_PAD src0_sel:DWORD src1_sel:WORD_0
    v_add_u32_sdwa v242, v2, v217 dst_sel:DWORD dst_unused:UNUSED_PAD src0_sel:DWORD src1_sel:WORD_1
    ds_read_b64 v[236:237], v236
    ds_read_b64 v[238:239], v238
    ds_read_b64 v[240:241], v240
    ds_read_b64 v[242:243], v242
L_g1:
    v_smfmac_f32_32x32x32_bf16 v[56:71], a[164:167], v[88:95], v34
    ds_read_b128 v[116:119], v1 offset:1504
    s_waitcnt lgkmcnt(10)
    v_smfmac_f32_32x32x32_bf16 v[40:55], a[168:171], v[96:103], v18 abid:1
    ds_read_b128 v[88:91], v1 offset:1536
    ds_write_b128 v0, v[84:87] offset:96
    v_smfmac_f32_32x32x32_bf16 v[56:71], a[172:175], v[96:103], v34 abid:1
    ds_read_b128 v[92:95], v1 offset:1568
    s_waitcnt lgkmcnt(4)
    v_smfmac_f32_32x32x32_bf16 v[56:71], v[184:187], v[244:251], v202 abid:1
    s_waitcnt lgkmcnt(8)
    v_smfmac_f32_32x32x32_bf16 v[40:55], a[176:179], v[104:111], v19
    ds_read_b128 v[96:99], v1 offset:1600
    s_cmp_le_u32 s31, 6
    s_cbranch_scc1 L_g2
    v_add_u32_sdwa v244, v2, v232 dst_sel:DWORD dst_unused:UNUSED_PAD src0_sel:DWORD src1_sel:WORD_0
    v_add_u32_sdwa v246, v2, v232 dst_sel:DWORD dst_unused:UNUSED_PAD src0_sel:DWORD src1_sel:WORD_1
    v_add_u32_sdwa v248, v2, v233 dst_sel:DWORD dst_unused:UNUSED_PAD src0_sel:DWORD src1_sel:WORD_0
    v_add_u32_sdwa v250, v2, v233 dst_sel:DWORD dst_unused:UNUSED_PAD src0_sel:DWORD src1_sel:WORD_1
    ds_read_b64 v[244:245], v244
    ds_read_b64 v[246:247], v246
    ds_read_b64 v[248:249], v248
    ds_read_b64 v[250:251], v250
L_g2:
    v_smfmac_f32_32x32x32_bf16 v[56:71], a[180:183], v[104:111], v35
    ds_read_b128 v[100:103], v1 offset:1632
    s_waitcnt lgkmcnt(5)
    v_smfmac_f32_32x32x32_bf16 v[40:55], a[184:187], v[112:119], v19 abid:1
    ds_read_b128 v[104:107], v1 offset:1664
    s_cmp_le_u32 s30, 6
    s_cbranch_scc1 L_m3
    s_waitcnt lgkmcnt(7)
    v_smfmac_f32_32x32x32_bf16 v[40:55], v[156:159], v[236:243], v199
L_m3:
    ds_read_b128 v[72:75], v6 offset:0
    v_smfmac_f32_32x32x32_bf16 v[56:71], a[188:191], v[112:119], v35 abid:1
    ds_read_b128 v[108:111], v1 offset:1696
    s_cmp_le_u32 s30, 7
    s_cbranch_scc1 L_g4
    v_add_u32_sdwa v236, v2, v218 dst_sel:DWORD dst_unused:UNUSED_PAD src0_sel:DWORD src1_sel:WORD_0
    v_add_u32_sdwa v238, v2, v218 dst_sel:DWORD dst_unused:UNUSED_PAD src0_sel:DWORD src1_sel:WORD_1
    v_add_u32_sdwa v240, v2, v219 dst_sel:DWORD dst_unused:UNUSED_PAD src0_sel:DWORD src1_sel:WORD_0
    v_add_u32_sdwa v242, v2, v219 dst_sel:DWORD dst_unused:UNUSED_PAD src0_sel:DWORD src1_sel:WORD_1
    ds_read_b64 v[236:237], v236
    ds_read_b64 v[238:239], v238
    ds_read_b64 v[240:241], v240
    ds_read_b64 v[242:243], v242
L_g4:
    ds_read_b128 v[76:79], v6 offset:1152
    s_waitcnt lgkmcnt(6)
    v_smfmac_f32_32x32x32_bf16 v[40:55], a[192:195], v[88:95], v20
    ds_read_b128 v[112:115], v1 offset:1728
    ds_read_b128 v[80:83], v6 offset:2304
    v_smfmac_f32_32x32x32_bf16 v[56:71], a[196:199], v[88:95], v36
    ds_read_b128 v[116:119], v1 offset:1760
    ds_read_b128 v[84:87], v6 offset:3456
    s_waitcnt lgkmcnt(8)
    v_smfmac_f32_32x32x32_bf16 v[40:55], a[200:203], v[96:103], v20 abid:1
    ds_read_b128 v[88:91], v1 offset:1792
    s_cmp_le_u32 s31, 6
    s_cbranch_scc1 L_m5
    s_waitcnt lgkmcnt(10)
    v_smfmac_f32_32x32x32_bf16 v[56:71], v[188:191], v[244:251], v203
L_m5:
    v_smfmac_f32_32x32x32_bf16 v[56:71], a[204:207], v[96:103], v36 abid:1
    ds_read_b128 v[92:95], v1 offset:1824
    s_cmp_le_u32 s31, 7
    s_cbranch_scc1 L_g6
    v_add_u32_sdwa v244, v2, v234 dst_sel:DWORD dst_unused:UNUSED_PAD src0_sel:DWORD src1_sel:WORD_0
    v_add_u32_sdwa v246, v2, v234 dst_sel:DWORD dst_unused:UNUSED_PAD src0_sel:DWORD src1_sel:WORD_1
    v_add_u32_sdwa v248, v2, v235 dst_sel:DWORD dst_unused:UNUSED_PAD src0_sel:DWORD src1_sel:WORD_0
    v_add_u32_sdwa v250, v2, v235 dst_sel:DWORD dst_unused:UNUSED_PAD src0_sel:DWORD src1_sel:WORD_1
    ds_read_b64 v[244:245], v244
    ds_read_b64 v[246:247], v246
    ds_read_b64 v[248:249], v248
    ds_read_b64 v[250:251], v250
L_g6:
    s_waitcnt lgkmcnt(7)
    v_smfmac_f32_32x32x32_bf16 v[40:55], a[208:211], v[104:111], v21
    ds_read_b128 v[96:99], v1 offset:1856
    v_smfmac_f32_32x32x32_bf16 v[56:71], a[212:215], v[104:111], v37
    ds_read_b128 v[100:103], v1 offset:1888
    s_cmp_le_u32 s30, 7
    s_cbranch_scc1 L_m7
    s_waitcnt lgkmcnt(9)
    v_smfmac_f32_32x32x32_bf16 v[40:55], v[160:163], v[236:243], v199 abid:1
L_m7:
    s_waitcnt lgkmcnt(5)
    v_smfmac_f32_32x32x32_bf16 v[40:55], a[216:219], v[112:119], v21 abid:1
    ds_read_b128 v[104:107], v1 offset:1920
    s_waitcnt lgkmcnt(11)
    s_add_u32 s38, s34, 0
    buffer_store_dwordx4 v[72:75], v4, s[16:19], s38 offen sc1
    v_smfmac_f32_32x32x32_bf16 v[56:71], a[220:223], v[112:119], v37 abid:1
    ds_read_b128 v[108:111], v1 offset:1952
    s_waitcnt lgkmcnt(10)
    s_add_u32 s38, s34, 16384
    buffer_store_dwordx4 v[76:79], v4, s[16:19], s38 offen sc1
    s_waitcnt lgkmcnt(4)
    v_smfmac_f32_32x32x32_bf16 v[40:55], a[224:227], v[88:95], v22
    ds_read_b128 v[112:115], v1 offset:1984
    s_waitcnt lgkmcnt(9)
    s_add_u32 s38, s34, 32768
    buffer_store_dwordx4 v[80:83], v4, s[16:19], s38 offen sc1
    v_smfmac_f32_32x32x32_bf16 v[56:71], a[228:231], v[88:95], v38
    ds_read_b128 v[116:119], v1 offset:2016
    s_cmp_le_u32 s31, 7
    s_cbranch_scc1 L_m8
    s_waitcnt lgkmcnt(6)
    v_smfmac_f32_32x32x32_bf16 v[56:71], v[192:195], v[244:251], v203 abid:1
L_m8:
    s_waitcnt lgkmcnt(8)
    s_add_u32 s38, s34, 49152
    buffer_store_dwordx4 v[84:87], v4, s[16:19], s38 offen sc1
    s_or_b32 s36, s64, s65
    s_cbranch_scc0 L_sp_end
    v_lshrrev_b32 v249, 4, v3
    v_mov_b32 v238, 0
    v_mov_b32 v239, 0
    v_mov_b32 v240, 0
    v_mov_b32 v241, 0
    v_mov_b32 v242, 0
    v_mov_b32 v243, 0
    v_mov_b32 v245, 0
    v_mov_b32 v246, 0
    v_mov_b32 v247, 0
    s_mov_b32 s58, 0
L_sp_kr:
    s_cmp_lt_u32 s58, 64
    s_cselect_b32 s36, s64, s65
    s_cmp_eq_u32 s36, 0
    s_cbranch_scc1 L_sp_nx
    s_lshl_b32 s59, s28, 7
    s_add_u32 s59, s59, s58
    s_lshl_b32 s60, s59, 2
    buffer_load_dword v251, v245, s[20:23], s60 offen offset:0 sc1
    s_lshl_b32 s59, s59, 10
    s_add_u32 s59, s59, 0x200000
    s_waitcnt vmcnt(0)
    v_readfirstlane_b32 s60, v251
    s_nop 3
    s_cmp_eq_u32 s60, 0
    s_cbranch_scc1 L_sp_nx
L_sp_e:
    buffer_load_dword v251, v245, s[20:23], s59 offen sc1
    s_waitcnt vmcnt(0)
    v_readfirstlane_b32 s62, v251
    s_nop 3
    s_lshr_b32 s63, s62, 26
    v_cmp_eq_u32 vcc, s63, v249
    s_and_b32 s63, s62, 0xffff
    v_mov_b32 v250, s63
    s_bfe_u32 s63, s62, 0x80010
    s_lshl_b32 s63, s63, 3
    v_add_u32 v236, s63, v2
    v_cndmask_b32 v244, 0, v250, vcc
    s_bfe_u32 s63, s62, 0x20018
    v_mov_b32 v248, s63
    ds_read_b64 v[236:237], v236
    s_waitcnt lgkmcnt(0)
    s_cmp_lt_u32 s58, 64
    s_cbranch_scc0 L_sp_j1
    v_smfmac_f32_32x32x32_bf16 v[40:55], v[244:247], v[236:243], v248
    s_branch L_sp_jd
L_sp_j1:
    v_smfmac_f32_32x32x32_bf16 v[56:71], v[244:247], v[236:243], v248
L_sp_jd:
    s_add_u32 s59, s59, 4
    s_sub_u32 s60, s60, 1
    s_cmp_lg_u32 s60, 0
    s_nop 4
    s_cbranch_scc1 L_sp_e
L_sp_nx:
    s_add_u32 s58, s58, 1
    s_cmp_lt_u32 s58, 128
    s_cbranch_scc1 L_sp_kr
L_sp_end:
    s_waitcnt lgkmcnt(4)
    v_smfmac_f32_32x32x32_bf16 v[40:55], a[232:235], v[96:103], v22 abid:1
    v_smfmac_f32_32x32x32_bf16 v[56:71], a[236:239], v[96:103], v38 abid:1
    s_waitcnt vmcnt(5) lgkmcnt(0)
    s_barrier
    v_add_u32 v1, s29, v1
    v_add_u32 v2, s29, v2
    ds_read_b128 v[88:91], v1 offset:0
    ds_read_b128 v[92:95], v1 offset:32
    v_smfmac_f32_32x32x32_bf16 v[40:55], a[240:243], v[104:111], v23
    ds_read_b128 v[96:99], v1 offset:64
    ds_read_b128 v[100:103], v1 offset:96
    s_sub_u32 s32, s32, s29
    s_sub_u32 s29, 0, s29
    v_smfmac_f32_32x32x32_bf16 v[40:55], a[248:251], v[112:119], v23 abid:1
    s_mov_b32 s34, s33
    s_add_u32 s33, s33, 0x10000
    s_add_u32 s37, s37, 0x10000
    s_add_u32 s41, s41, 0x10000
    s_add_u32 s39, s39, 1
    v_smfmac_f32_32x32x32_bf16 v[56:71], a[244:247], v[104:111], v39
    ds_read_b128 v[104:107], v1 offset:128
    ds_read_b128 v[108:111], v1 offset:160
    s_cmp_lt_u32 s39, 8
    s_nop 2
    v_smfmac_f32_32x32x32_bf16 v[56:71], a[252:255], v[112:119], v39 abid:1
    v_cvt_pk_bf16_f32 v72, v40, v41
    v_cvt_pk_bf16_f32 v73, v42, v43
    v_cvt_pk_bf16_f32 v74, v44, v45
    v_cvt_pk_bf16_f32 v75, v46, v47
    v_cvt_pk_bf16_f32 v76, v48, v49
    v_cvt_pk_bf16_f32 v77, v50, v51
    v_cvt_pk_bf16_f32 v78, v52, v53
    v_cvt_pk_bf16_f32 v79, v54, v55
    v_mfma_f32_32x32x16_bf16 v[40:55], v[120:123], v[128:131], 0
    s_cbranch_scc1 L_loop
    s_nop 7
    v_cvt_pk_bf16_f32 v80, v56, v57
    v_cvt_pk_bf16_f32 v81, v58, v59
    v_cvt_pk_bf16_f32 v82, v60, v61
    v_cvt_pk_bf16_f32 v83, v62, v63
    v_cvt_pk_bf16_f32 v84, v64, v65
    v_cvt_pk_bf16_f32 v85, v66, v67
    v_cvt_pk_bf16_f32 v86, v68, v69
    v_cvt_pk_bf16_f32 v87, v70, v71
    s_nop 1
    ds_write_b128 v0, v[72:75] offset:0
    ds_write_b128 v0, v[76:79] offset:32
    ds_write_b128 v0, v[80:83] offset:64
    ds_write_b128 v0, v[84:87] offset:96
    ds_read_b128 v[72:75], v6 offset:0
    ds_read_b128 v[76:79], v6 offset:1152
    ds_read_b128 v[80:83], v6 offset:2304
    ds_read_b128 v[84:87], v6 offset:3456
    s_waitcnt lgkmcnt(3)
    s_add_u32 s38, s34, 0
    buffer_store_dwordx4 v[72:75], v4, s[16:19], s38 offen sc1
    s_waitcnt lgkmcnt(2)
    s_add_u32 s38, s34, 16384
    buffer_store_dwordx4 v[76:79], v4, s[16:19], s38 offen sc1
    s_waitcnt lgkmcnt(1)
    s_add_u32 s38, s34, 32768
    buffer_store_dwordx4 v[80:83], v4, s[16:19], s38 offen sc1
    s_waitcnt lgkmcnt(0)
    s_add_u32 s38, s34, 49152
    buffer_store_dwordx4 v[84:87], v4, s[16:19], s38 offen sc1
L_main_end:
    s_endpgm

.section .rodata,"a"
.p2align 6
.amdhsa_kernel standalone__structured_sparse_n_m__ragged_kernel
  .amdhsa_next_free_vgpr 512
  .amdhsa_next_free_sgpr 102
  .amdhsa_accum_offset 256
  .amdhsa_group_segment_fixed_size 0
  .amdhsa_kernarg_size 48
  .amdhsa_user_sgpr_count 2
  .amdhsa_user_sgpr_kernarg_segment_ptr 1
  .amdhsa_system_sgpr_workgroup_id_x 1
.end_amdhsa_kernel
```
